```python
import torch

def _softmax(x, axis=-1):
    return torch.softmax(x, dim=axis)
def _gelu(x):
    return torch.nn.functional.gelu(x, approximate="tanh")
def _silu(x):
    return torch.nn.functional.silu(x)
def _sigmoid(x):
    return torch.sigmoid(x)
def _layernorm(x, axis=-1, eps=1e-5):
    m = x.mean(dim=axis, keepdim=True)
    v = x.var(dim=axis, keepdim=True, unbiased=False)
    return (x - m) / torch.sqrt(v + eps)
def _scatter_add(tgt, idx, src, axis=0):
    return tgt.clone().index_add_(axis, idx, src)
def _segment_sum(src, seg, n):
    out = torch.zeros((n,) + src.shape[1:], dtype=src.dtype)
    return out.index_add_(0, seg, src)
def _pad(x, pw):
    flat = tuple(v for pair in reversed(pw) for v in pair)
    return torch.nn.functional.pad(x, flat)

kernel_name = 'recurrent_scan__mha_block_cached__dense_activation_gelu__decode'

def setup_inputs():

    _w = (lambda a: (lambda t: t.to(torch.bfloat16) if t.is_floating_point() else t)(torch.as_tensor(a)))
    def _A_setup():
        B, Sq, D = 1, 1, 640
        H, Sk, Dh = 32, 32768, 192
        return {
            "x": _w((lambda *s: torch.randn(*s, dtype=torch.bfloat16) * 0.4)(B, Sq, D)),
            "k_cache": _w((lambda *s: torch.randn(*s, dtype=torch.bfloat16) * 1.6)(B, H, Sk, Dh)),
            "v_cache": _w((lambda *s: torch.randn(*s, dtype=torch.bfloat16) * 1.6)(B, H, Sk, Dh)),
            "wq": _w((lambda *s: torch.randn(*s, dtype=torch.bfloat16) * 1.6)(D, H * Dh) * (D ** -0.5)),
            "wo": _w((lambda *s: torch.randn(*s, dtype=torch.bfloat16) * 1.6)(H * Dh, D) * ((H * Dh) ** -0.5)),
        }
    _A_in = _A_setup()

    def _B_setup():
        B, S, D, F = 1, 1, 640, 1536
        return {
            "x": _w((lambda *s: torch.randn(*s, dtype=torch.bfloat16) * 0.4)(B, S, D)),
            "w1": _w((lambda *s: torch.randn(*s, dtype=torch.bfloat16) * 1.6)(D, F) * (D ** -0.5)),
            "b1": _w((lambda *s: torch.randn(*s, dtype=torch.bfloat16) * 1.6)(F) * 0.01),
            "w2": _w((lambda *s: torch.randn(*s, dtype=torch.bfloat16) * 1.6)(F, D) * (F ** -0.5)),
            "b2": _w((lambda *s: torch.randn(*s, dtype=torch.bfloat16) * 1.6)(D) * 0.01),
        }
    _B_in = _B_setup()

    return {
        "A_x": _A_in["x"],
        "A_k_cache": _A_in["k_cache"],
        "A_v_cache": _A_in["v_cache"],
        "A_wq": _A_in["wq"],
        "A_wo": _A_in["wo"],
        "B_x": _B_in["x"],
        "B_w1": _B_in["w1"],
        "B_b1": _B_in["b1"],
        "B_w2": _B_in["w2"],
        "B_b2": _B_in["b2"],
    }

def reference(A_x, A_k_cache, A_v_cache, A_wq, A_wo, B_x, B_w1, B_b1, B_w2, B_b2):
    def _A_ref(x, k_cache, v_cache, wq, wo):
        B, Sq, D = x.shape
        H, Dh = 32, 192
        q = (lambda x, *d: x.permute(*d))((x @ wq).reshape(B, Sq, H, Dh), 0, 2, 1, 3)
        scores = torch.einsum("bhqd,bhkd->bhqk", q, k_cache) * (Dh ** -0.5)
        p = _softmax(scores, axis=-1)
        o = torch.einsum("bhqk,bhkd->bhqd", p, v_cache)
        return (lambda x, *d: x.permute(*d))(o, 0, 2, 1, 3).reshape(B, Sq, H * Dh) @ wo

    def _B_ref(x, w1, b1, w2, b2):
        h = torch.einsum("bsd,df->bsf", x, w1) + b1
        h = _gelu(h)
        return torch.einsum("bsf,fd->bsd", h, w2) + b2

    x = A_x
    xn = _layernorm(x, axis=-1)
    s = _A_ref(xn, A_k_cache, A_v_cache, A_wq, A_wo)
    g = _silu(_B_ref(xn, B_w1, B_b1, B_w2, B_b2))
    return x + s * g
```

```asm
; @launch grid=(256,1,1) block=(512,1,1) lds=43008
.amdgcn_target "amdgcn-amd-amdhsa--gfx950"
.text
.globl recurrent_scan__mha_block_cached__dense_activation_gelu__decode_kernel
.p2align 8
.type recurrent_scan__mha_block_cached__dense_activation_gelu__decode_kernel,@function
recurrent_scan__mha_block_cached__dense_activation_gelu__decode_kernel:
    s_cmp_ge_u32 s2, 256
    s_cbranch_scc1 L_exit
    s_setprio 3
    s_load_dwordx16 s[4:19], s[0:1], 0
    s_load_dwordx8 s[20:27], s[0:1], 64
    s_load_dwordx2 s[28:29], s[0:1], 96
    v_and_b32 v2, 63, v0
    v_lshrrev_b32 v6, 6, v0
    s_nop 0
    v_readfirstlane_b32 s76, v6
    s_lshr_b32 s77, s2, 3
    s_and_b32 s78, s2, 7
    s_mov_b32 s90, 0xffff0000
    s_mov_b32 s91, 0x3fb8aa3b
    s_mov_b32 s92, 0x3d93cd3a
    v_lshrrev_b32 v6, 3, v2
    v_and_b32 v7, 7, v2
    v_lshlrev_b32 v7, 4, v7
    v_mul_u32_u24 v1, 384, v6
    v_add_u32 v1, v1, v7
    v_mov_b32 v52, 0
    s_mul_i32 s83, s77, 21
    s_lshl_b32 s88, s78, 3
    s_add_u32 s88, s88, s76
    s_add_u32 s89, s88, 64
    s_lshl_b32 s79, s2, 10
    s_add_u32 s79, s79, 65536
    s_mul_i32 s80, s2, 2560
    s_add_u32 s93, s80, 979456
    s_add_u32 s80, s80, 326656
    v_mov_b32 v8, s79
    v_mov_b32 v9, s80
    v_mov_b32 v10, s93
    v_cmp_le_u32 vcc, 64, v0
    s_nop 1
    v_cndmask_b32 v8, v8, v9, vcc
    v_cmp_le_u32 vcc, 224, v0
    s_nop 1
    v_cndmask_b32 v8, v8, v10, vcc
    v_lshl_add_u32 v8, v0, 4, v8
    v_mov_b32 v12, -1
    v_mov_b32 v13, -1
    v_mov_b32 v14, -1
    v_mov_b32 v15, -1
    s_waitcnt lgkmcnt(0)
    s_mov_b32 s40, s28
    s_and_b32 s41, s29, 0xffff
    s_mov_b32 s42, 8388608
    s_mov_b32 s43, 0x00020000
    v_cmp_gt_u32 vcc, 384, v0
    s_and_saveexec_b64 s[94:95], vcc
    s_cbranch_execz L_noclr
    buffer_store_dwordx4 v[12:15], v8, s[40:43], 0 offen sc1
L_noclr:
    s_mov_b64 exec, -1
    s_lshl_b32 s79, s77, 8
    s_or_b32 s80, s78, s76
    s_cmp_lg_u32 s80, 0
    s_cbranch_scc1 L_nocnt
    s_mov_b64 exec, 1
    buffer_store_dword v52, v52, s[40:43], s79 offen sc1
    s_mov_b64 exec, -1
L_nocnt:
    s_add_u32 s84, s28, s79
    s_addc_u32 s85, s29, 0
    s_lshl_b32 s79, s77, 2
    s_add_u32 s86, s26, s79
    s_addc_u32 s87, s27, 0
    s_mov_b32 s44, s4
    s_and_b32 s45, s5, 0xffff
    s_mov_b32 s46, 1280
    s_mov_b32 s47, 0x00020000
    v_lshlrev_b32 v9, 2, v2
    buffer_load_dword v180, v9, s[44:47], 0 offen offset:0
    buffer_load_dword v181, v9, s[44:47], 0 offen offset:256
    buffer_load_dword v182, v9, s[44:47], 0 offen offset:512
    buffer_load_dword v183, v9, s[44:47], 0 offen offset:768
    buffer_load_dword v184, v9, s[44:47], 0 offen offset:1024
    s_cmp_ge_u32 s76, 6
    s_cbranch_scc1 L_w1
    s_mov_b32 s48, s10
    s_and_b32 s49, s11, 0xffff
    s_mov_b32 s50, 7864320
    s_mov_b32 s51, 0x00020000
    s_cmp_ge_u32 s76, 3
    s_cselect_b32 s80, 1, 0
    s_mul_i32 s93, s80, 3
    s_sub_u32 s93, s76, s93
    s_mul_i32 s79, s78, 80
    s_mul_i32 s81, s80, 40
    s_add_u32 s79, s79, s81
    s_mul_i32 s81, s79, 12288
    s_mul_i32 s82, s77, 384
    s_add_u32 s81, s81, s82
    s_lshl_b32 s82, s93, 7
    s_add_u32 s81, s81, s82
    v_mul_u32_u24 v10, 12288, v6
    v_add_u32 v10, v10, v7
    buffer_load_dwordx4 v[160:163], v10, s[48:51], s81 offen nt
    s_add_u32 s81, s81, 98304
    buffer_load_dwordx4 v[164:167], v10, s[48:51], s81 offen nt
    s_add_u32 s81, s81, 98304
    buffer_load_dwordx4 v[168:171], v10, s[48:51], s81 offen nt
    s_add_u32 s81, s81, 98304
    buffer_load_dwordx4 v[172:175], v10, s[48:51], s81 offen nt
    s_add_u32 s81, s81, 98304
    buffer_load_dwordx4 v[176:179], v10, s[48:51], s81 offen nt
    v_add_u32 v11, s79, v6
    s_branch L_wdone
L_w1:
    s_mov_b32 s48, s16
    s_and_b32 s49, s17, 0xffff
    s_mov_b32 s50, 1966080
    s_mov_b32 s51, 0x00020000
    v_mul_u32_u24 v11, 10923, v2
    v_lshrrev_b32 v11, 16, v11
    v_mul_u32_u24 v5, 6, v11
    v_sub_u32 v5, v2, v5
    v_mul_u32_u24 v10, 3072, v11
    v_lshl_add_u32 v10, v5, 4, v10
    s_sub_u32 s80, s76, 6
    s_mul_i32 s79, s78, 80
    s_mul_i32 s81, s80, 40
    s_add_u32 s79, s79, s81
    s_mul_i32 s81, s79, 3072
    s_mul_i32 s82, s77, 96
    s_add_u32 s81, s81, s82
    buffer_load_dwordx4 v[160:163], v10, s[48:51], s81 offen nt
    s_add_u32 s81, s81, 30720
    buffer_load_dwordx4 v[164:167], v10, s[48:51], s81 offen nt
    s_add_u32 s81, s81, 30720
    buffer_load_dwordx4 v[168:171], v10, s[48:51], s81 offen nt
    s_add_u32 s81, s81, 30720
    buffer_load_dwordx4 v[172:175], v10, s[48:51], s81 offen nt
    buffer_load_dwordx4 v[176:179], v10, s[48:51], s81 offen nt
    v_mov_b32 v3, v11
    v_add_u32 v11, s79, v11
L_wdone:
    s_mov_b32 s68, s18
    s_and_b32 s69, s19, 0xffff
    s_mov_b32 s70, 3072
    s_mov_b32 s71, 0x00020000
    v_subrev_u32 v10, 192, v0
    v_lshlrev_b32 v10, 1, v10
    s_mul_i32 s82, s77, 96
    buffer_load_ushort v202, v10, s[68:71], s82 offen
    s_mul_i32 s81, s77, 12582912
    s_add_u32 s32, s6, s81
    s_addc_u32 s33, s7, 0
    s_and_b32 s33, s33, 0xffff
    s_mov_b32 s34, 12582912
    s_mov_b32 s35, 0x00020000
    s_add_u32 s36, s8, s81
    s_addc_u32 s37, s9, 0
    s_and_b32 s37, s37, 0xffff
    s_mov_b32 s38, 12582912
    s_mov_b32 s39, 0x00020000
    s_mov_b32 s52, s12
    s_and_b32 s53, s13, 0xffff
    s_mov_b32 s54, 7864320
    s_mov_b32 s55, 0x00020000
    s_mov_b32 s56, s20
    s_and_b32 s57, s21, 0xffff
    s_mov_b32 s58, 1966080
    s_mov_b32 s59, 0x00020000
    s_mov_b32 s60, s22
    s_and_b32 s61, s23, 0xffff
    s_mov_b32 s62, 1280
    s_mov_b32 s63, 0x00020000
    s_mov_b32 s64, s24
    s_and_b32 s65, s25, 0xffff
    s_mov_b32 s66, 1280
    s_mov_b32 s67, 0x00020000
    s_mov_b32 s72, s26
    s_and_b32 s73, s27, 0xffff
    s_mov_b32 s74, 128
    s_mov_b32 s75, 0x00020000
    s_barrier
    s_add_u32 s81, s88, s83
    s_and_b32 s81, s81, 2047
    s_mul_i32 s81, s81, 6144
    s_cmp_lt_u32 s88, 2048
    s_cselect_b32 s81, s81, 0x7f000000
    buffer_load_dwordx4 v[64:67], v1, s[32:35], s81 offen offset:0 nt
    buffer_load_dwordx4 v[68:71], v1, s[32:35], s81 offen offset:128 nt
    buffer_load_dwordx4 v[72:75], v1, s[32:35], s81 offen offset:256 nt
    buffer_load_dwordx4 v[76:79], v1, s[32:35], s81 offen offset:3072 nt
    buffer_load_dwordx4 v[80:83], v1, s[32:35], s81 offen offset:3200 nt
    buffer_load_dwordx4 v[84:87], v1, s[32:35], s81 offen offset:3328 nt
    s_waitcnt vmcnt(12)
    v_lshlrev_b32 v186, 16, v180
    v_and_b32 v187, s90, v180
    v_lshlrev_b32 v188, 16, v181
    v_and_b32 v189, s90, v181
    v_lshlrev_b32 v190, 16, v182
    v_and_b32 v191, s90, v182
    v_lshlrev_b32 v192, 16, v183
    v_and_b32 v193, s90, v183
    v_lshlrev_b32 v194, 16, v184
    v_and_b32 v195, s90, v184
    v_add_f32 v12, v186, v187
    v_add_f32 v12, v12, v188
    v_add_f32 v12, v12, v189
    v_add_f32 v12, v12, v190
    v_add_f32 v12, v12, v191
    v_add_f32 v12, v12, v192
    v_add_f32 v12, v12, v193
    v_add_f32 v12, v12, v194
    v_add_f32 v12, v12, v195
    s_nop 1
    v_add_f32_dpp v12, v12, v12 quad_perm:[1,0,3,2] row_mask:0xf bank_mask:0xf
    s_nop 1
    v_add_f32_dpp v12, v12, v12 quad_perm:[2,3,0,1] row_mask:0xf bank_mask:0xf
    s_nop 1
    v_add_f32_dpp v12, v12, v12 row_half_mirror row_mask:0xf bank_mask:0xf
    s_nop 1
    v_add_f32_dpp v12, v12, v12 row_ror:8 row_mask:0xf bank_mask:0xf
    s_nop 1
    v_mov_b32 v13, v12
    s_nop 1
    v_permlane16_swap_b32 v12, v13
    v_add_f32 v12, v12, v13
    s_nop 1
    v_mov_b32 v13, v12
    s_nop 1
    v_permlane32_swap_b32 v12, v13
    v_add_f32 v12, v12, v13
    v_mul_f32 v12, 0x3acccccd, v12
    v_mov_b32 v13, 0
    v_sub_f32 v14, v186, v12
    v_fmac_f32 v13, v14, v14
    v_sub_f32 v14, v187, v12
    v_fmac_f32 v13, v14, v14
    v_sub_f32 v14, v188, v12
    v_fmac_f32 v13, v14, v14
    v_sub_f32 v14, v189, v12
    v_fmac_f32 v13, v14, v14
    v_sub_f32 v14, v190, v12
    v_fmac_f32 v13, v14, v14
    v_sub_f32 v14, v191, v12
    v_fmac_f32 v13, v14, v14
    v_sub_f32 v14, v192, v12
    v_fmac_f32 v13, v14, v14
    v_sub_f32 v14, v193, v12
    v_fmac_f32 v13, v14, v14
    v_sub_f32 v14, v194, v12
    v_fmac_f32 v13, v14, v14
    v_sub_f32 v14, v195, v12
    v_fmac_f32 v13, v14, v14
    s_nop 1
    v_add_f32_dpp v13, v13, v13 quad_perm:[1,0,3,2] row_mask:0xf bank_mask:0xf
    s_nop 1
    v_add_f32_dpp v13, v13, v13 quad_perm:[2,3,0,1] row_mask:0xf bank_mask:0xf
    s_nop 1
    v_add_f32_dpp v13, v13, v13 row_half_mirror row_mask:0xf bank_mask:0xf
    s_nop 1
    v_add_f32_dpp v13, v13, v13 row_ror:8 row_mask:0xf bank_mask:0xf
    s_nop 1
    v_mov_b32 v14, v13
    s_nop 1
    v_permlane16_swap_b32 v13, v14
    v_add_f32 v13, v13, v14
    s_nop 1
    v_mov_b32 v14, v13
    s_nop 1
    v_permlane32_swap_b32 v13, v14
    v_add_f32 v13, v13, v14
    v_mul_f32 v13, 0x3acccccd, v13
    v_cvt_pk_bf16_f32 v14, v12, v13
    v_lshlrev_b32 v12, 16, v14
    v_and_b32 v13, 0xffff0000, v14
    v_add_f32 v13, 0x3727c5ac, v13
    v_cvt_pk_bf16_f32 v14, v13, v13
    v_lshlrev_b32 v13, 16, v14
    v_sqrt_f32 v13, v13
    s_nop 0
    v_cvt_pk_bf16_f32 v14, v13, v13
    v_lshlrev_b32 v13, 16, v14
    v_rcp_f32 v15, v13
    v_sub_f32 v186, v186, v12
    v_sub_f32 v187, v187, v12
    v_sub_f32 v188, v188, v12
    v_sub_f32 v189, v189, v12
    v_sub_f32 v190, v190, v12
    v_sub_f32 v191, v191, v12
    v_sub_f32 v192, v192, v12
    v_sub_f32 v193, v193, v12
    v_sub_f32 v194, v194, v12
    v_sub_f32 v195, v195, v12
    v_cvt_pk_bf16_f32 v14, v186, v187
    v_lshlrev_b32 v186, 16, v14
    v_and_b32 v187, 0xffff0000, v14
    v_cvt_pk_bf16_f32 v14, v188, v189
    v_lshlrev_b32 v188, 16, v14
    v_and_b32 v189, 0xffff0000, v14
    v_cvt_pk_bf16_f32 v14, v190, v191
    v_lshlrev_b32 v190, 16, v14
    v_and_b32 v191, 0xffff0000, v14
    v_cvt_pk_bf16_f32 v14, v192, v193
    v_lshlrev_b32 v192, 16, v14
    v_and_b32 v193, 0xffff0000, v14
    v_cvt_pk_bf16_f32 v14, v194, v195
    v_lshlrev_b32 v194, 16, v14
    v_and_b32 v195, 0xffff0000, v14
    v_mul_f32 v14, v186, v15
    v_fma_f32 v16, -v14, v13, v186
    v_fma_f32 v186, v16, v15, v14
    v_mul_f32 v14, v187, v15
    v_fma_f32 v16, -v14, v13, v187
    v_fma_f32 v187, v16, v15, v14
    v_mul_f32 v14, v188, v15
    v_fma_f32 v16, -v14, v13, v188
    v_fma_f32 v188, v16, v15, v14
    v_mul_f32 v14, v189, v15
    v_fma_f32 v16, -v14, v13, v189
    v_fma_f32 v189, v16, v15, v14
    v_mul_f32 v14, v190, v15
    v_fma_f32 v16, -v14, v13, v190
    v_fma_f32 v190, v16, v15, v14
    v_mul_f32 v14, v191, v15
    v_fma_f32 v16, -v14, v13, v191
    v_fma_f32 v191, v16, v15, v14
    v_mul_f32 v14, v192, v15
    v_fma_f32 v16, -v14, v13, v192
    v_fma_f32 v192, v16, v15, v14
    v_mul_f32 v14, v193, v15
    v_fma_f32 v16, -v14, v13, v193
    v_fma_f32 v193, v16, v15, v14
    v_mul_f32 v14, v194, v15
    v_fma_f32 v16, -v14, v13, v194
    v_fma_f32 v194, v16, v15, v14
    v_mul_f32 v14, v195, v15
    v_fma_f32 v16, -v14, v13, v195
    v_fma_f32 v195, v16, v15, v14
    v_cvt_pk_bf16_f32 v14, v186, v187
    v_lshlrev_b32 v186, 16, v14
    v_and_b32 v187, 0xffff0000, v14
    v_cvt_pk_bf16_f32 v14, v188, v189
    v_lshlrev_b32 v188, 16, v14
    v_and_b32 v189, 0xffff0000, v14
    v_cvt_pk_bf16_f32 v14, v190, v191
    v_lshlrev_b32 v190, 16, v14
    v_and_b32 v191, 0xffff0000, v14
    v_cvt_pk_bf16_f32 v14, v192, v193
    v_lshlrev_b32 v192, 16, v14
    v_and_b32 v193, 0xffff0000, v14
    v_cvt_pk_bf16_f32 v14, v194, v195
    v_lshlrev_b32 v194, 16, v14
    v_and_b32 v195, 0xffff0000, v14
    s_mul_i32 s81, s76, 2560
    v_lshlrev_b32 v14, 3, v2
    v_add_u32 v14, s81, v14
    ds_write_b64 v14, v[186:187] offset:0
    ds_write_b64 v14, v[188:189] offset:512
    ds_write_b64 v14, v[190:191] offset:1024
    ds_write_b64 v14, v[192:193] offset:1536
    ds_write_b64 v14, v[194:195] offset:2048
    v_lshlrev_b32 v11, 2, v11
    v_add_u32 v11, s81, v11
    s_waitcnt lgkmcnt(0)
    s_cmp_ge_u32 s76, 6
    s_cbranch_scc1 L_p_w1
    ds_read_b32 v196, v11 offset:0
    ds_read_b32 v197, v11 offset:32
    ds_read_b32 v198, v11 offset:64
    ds_read_b32 v199, v11 offset:96
    ds_read_b32 v200, v11 offset:128
    s_waitcnt vmcnt(11) lgkmcnt(4)
    v_lshlrev_b32 v58, 16, v160
    v_and_b32 v59, s90, v160
    v_mul_f32 v12, v196, v58
    v_mul_f32 v13, v196, v59
    v_lshlrev_b32 v58, 16, v161
    v_and_b32 v59, s90, v161
    v_mul_f32 v14, v196, v58
    v_mul_f32 v15, v196, v59
    v_lshlrev_b32 v58, 16, v162
    v_and_b32 v59, s90, v162
    v_mul_f32 v16, v196, v58
    v_mul_f32 v17, v196, v59
    v_lshlrev_b32 v58, 16, v163
    v_and_b32 v59, s90, v163
    v_mul_f32 v18, v196, v58
    v_mul_f32 v19, v196, v59
    s_waitcnt vmcnt(10) lgkmcnt(3)
    v_lshlrev_b32 v58, 16, v164
    v_and_b32 v59, s90, v164
    v_fmac_f32 v12, v197, v58
    v_fmac_f32 v13, v197, v59
    v_lshlrev_b32 v58, 16, v165
    v_and_b32 v59, s90, v165
    v_fmac_f32 v14, v197, v58
    v_fmac_f32 v15, v197, v59
    v_lshlrev_b32 v58, 16, v166
    v_and_b32 v59, s90, v166
    v_fmac_f32 v16, v197, v58
    v_fmac_f32 v17, v197, v59
    v_lshlrev_b32 v58, 16, v167
    v_and_b32 v59, s90, v167
    v_fmac_f32 v18, v197, v58
    v_fmac_f32 v19, v197, v59
    s_waitcnt vmcnt(9) lgkmcnt(2)
    v_lshlrev_b32 v58, 16, v168
    v_and_b32 v59, s90, v168
    v_fmac_f32 v12, v198, v58
    v_fmac_f32 v13, v198, v59
    v_lshlrev_b32 v58, 16, v169
    v_and_b32 v59, s90, v169
    v_fmac_f32 v14, v198, v58
    v_fmac_f32 v15, v198, v59
    v_lshlrev_b32 v58, 16, v170
    v_and_b32 v59, s90, v170
    v_fmac_f32 v16, v198, v58
    v_fmac_f32 v17, v198, v59
    v_lshlrev_b32 v58, 16, v171
    v_and_b32 v59, s90, v171
    v_fmac_f32 v18, v198, v58
    v_fmac_f32 v19, v198, v59
    s_waitcnt vmcnt(8) lgkmcnt(1)
    v_lshlrev_b32 v58, 16, v172
    v_and_b32 v59, s90, v172
    v_fmac_f32 v12, v199, v58
    v_fmac_f32 v13, v199, v59
    v_lshlrev_b32 v58, 16, v173
    v_and_b32 v59, s90, v173
    v_fmac_f32 v14, v199, v58
    v_fmac_f32 v15, v199, v59
    v_lshlrev_b32 v58, 16, v174
    v_and_b32 v59, s90, v174
    v_fmac_f32 v16, v199, v58
    v_fmac_f32 v17, v199, v59
    v_lshlrev_b32 v58, 16, v175
    v_and_b32 v59, s90, v175
    v_fmac_f32 v18, v199, v58
    v_fmac_f32 v19, v199, v59
    s_waitcnt vmcnt(7) lgkmcnt(0)
    v_lshlrev_b32 v58, 16, v176
    v_and_b32 v59, s90, v176
    v_fmac_f32 v12, v200, v58
    v_fmac_f32 v13, v200, v59
    v_lshlrev_b32 v58, 16, v177
    v_and_b32 v59, s90, v177
    v_fmac_f32 v14, v200, v58
    v_fmac_f32 v15, v200, v59
    v_lshlrev_b32 v58, 16, v178
    v_and_b32 v59, s90, v178
    v_fmac_f32 v16, v200, v58
    v_fmac_f32 v17, v200, v59
    v_lshlrev_b32 v58, 16, v179
    v_and_b32 v59, s90, v179
    v_fmac_f32 v18, v200, v58
    v_fmac_f32 v19, v200, v59
    s_nop 1
    v_permlane32_swap_b32 v12, v16
    v_permlane32_swap_b32 v13, v17
    v_permlane32_swap_b32 v14, v18
    v_permlane32_swap_b32 v15, v19
    v_add_f32 v12, v12, v16
    v_add_f32 v13, v13, v17
    v_add_f32 v14, v14, v18
    v_add_f32 v15, v15, v19
    s_nop 1
    v_permlane16_swap_b32 v12, v14
    v_permlane16_swap_b32 v13, v15
    v_add_f32 v12, v12, v14
    v_add_f32 v13, v13, v15
    s_nop 1
    v_add_f32_dpp v12, v12, v12 row_ror:8 row_mask:0xf bank_mask:0xf
    v_add_f32_dpp v13, v13, v13 row_ror:8 row_mask:0xf bank_mask:0xf
    s_mul_i32 s81, s80, 768
    s_lshl_b32 s82, s93, 8
    s_add_u32 s81, s81, s82
    v_lshlrev_b32 v10, 1, v7
    v_lshrrev_b32 v5, 4, v2
    v_lshl_add_u32 v10, v5, 3, v10
    v_add_u32 v10, s81, v10
    ds_write_b64 v10, v[12:13] offset:20480
    s_branch L_p_done
L_p_w1:
    ds_read_b32 v196, v11 offset:0
    ds_read_b32 v197, v11 offset:40
    ds_read_b32 v198, v11 offset:80
    ds_read_b32 v199, v11 offset:120
    s_waitcnt vmcnt(11) lgkmcnt(3)
    v_lshlrev_b32 v58, 16, v160
    v_and_b32 v59, s90, v160
    v_mul_f32 v12, v196, v58
    v_mul_f32 v13, v196, v59
    v_lshlrev_b32 v58, 16, v161
    v_and_b32 v59, s90, v161
    v_mul_f32 v14, v196, v58
    v_mul_f32 v15, v196, v59
    v_lshlrev_b32 v58, 16, v162
    v_and_b32 v59, s90, v162
    v_mul_f32 v16, v196, v58
    v_mul_f32 v17, v196, v59
    v_lshlrev_b32 v58, 16, v163
    v_and_b32 v59, s90, v163
    v_mul_f32 v18, v196, v58
    v_mul_f32 v19, v196, v59
    s_waitcnt vmcnt(10) lgkmcnt(2)
    v_lshlrev_b32 v58, 16, v164
    v_and_b32 v59, s90, v164
    v_fmac_f32 v12, v197, v58
    v_fmac_f32 v13, v197, v59
    v_lshlrev_b32 v58, 16, v165
    v_and_b32 v59, s90, v165
    v_fmac_f32 v14, v197, v58
    v_fmac_f32 v15, v197, v59
    v_lshlrev_b32 v58, 16, v166
    v_and_b32 v59, s90, v166
    v_fmac_f32 v16, v197, v58
    v_fmac_f32 v17, v197, v59
    v_lshlrev_b32 v58, 16, v167
    v_and_b32 v59, s90, v167
    v_fmac_f32 v18, v197, v58
    v_fmac_f32 v19, v197, v59
    s_waitcnt vmcnt(9) lgkmcnt(1)
    v_lshlrev_b32 v58, 16, v168
    v_and_b32 v59, s90, v168
    v_fmac_f32 v12, v198, v58
    v_fmac_f32 v13, v198, v59
    v_lshlrev_b32 v58, 16, v169
    v_and_b32 v59, s90, v169
    v_fmac_f32 v14, v198, v58
    v_fmac_f32 v15, v198, v59
    v_lshlrev_b32 v58, 16, v170
    v_and_b32 v59, s90, v170
    v_fmac_f32 v16, v198, v58
    v_fmac_f32 v17, v198, v59
    v_lshlrev_b32 v58, 16, v171
    v_and_b32 v59, s90, v171
    v_fmac_f32 v18, v198, v58
    v_fmac_f32 v19, v198, v59
    s_waitcnt vmcnt(8) lgkmcnt(0)
    v_lshlrev_b32 v58, 16, v172
    v_and_b32 v59, s90, v172
    v_fmac_f32 v12, v199, v58
    v_fmac_f32 v13, v199, v59
    v_lshlrev_b32 v58, 16, v173
    v_and_b32 v59, s90, v173
    v_fmac_f32 v14, v199, v58
    v_fmac_f32 v15, v199, v59
    v_lshlrev_b32 v58, 16, v174
    v_and_b32 v59, s90, v174
    v_fmac_f32 v16, v199, v58
    v_fmac_f32 v17, v199, v59
    v_lshlrev_b32 v58, 16, v175
    v_and_b32 v59, s90, v175
    v_fmac_f32 v18, v199, v58
    v_fmac_f32 v19, v199, v59
    s_mul_i32 s81, s80, 1920
    v_mul_u32_u24 v10, 192, v3
    v_lshl_add_u32 v10, v5, 5, v10
    v_add_u32 v10, s81, v10
    v_cmp_gt_u32 vcc, 60, v2
    s_and_saveexec_b64 s[94:95], vcc
    ds_write_b128 v10, v[12:15] offset:22016
    ds_write_b128 v10, v[16:19] offset:22032
    s_mov_b64 exec, -1
L_p_done:
    s_waitcnt lgkmcnt(0)
    s_barrier
    v_lshlrev_b32 v10, 2, v0
    s_lshl_b32 s81, s2, 10
    s_add_u32 s81, s81, 1638400
    s_cmp_ge_u32 s76, 4
    s_cbranch_scc1 L_pub_done
    s_cmp_eq_u32 s76, 3
    s_cbranch_scc1 L_pub_h
    ds_read_b32 v12, v10 offset:20480
    ds_read_b32 v13, v10 offset:21248
    s_waitcnt lgkmcnt(0)
    v_add_f32 v12, v12, v13
    buffer_store_dword v12, v10, s[40:43], s81 offen sc1
    s_branch L_pub_done
L_pub_h:
    ds_read_b32 v12, v10 offset:21248
    ds_read_b32 v13, v10 offset:21440
    ds_read_b32 v14, v10 offset:21632
    ds_read_b32 v15, v10 offset:21824
    ds_read_b32 v16, v10 offset:22016
    ds_read_b32 v17, v10 offset:22208
    ds_read_b32 v18, v10 offset:22400
    ds_read_b32 v19, v10 offset:22592
    ds_read_b32 v20, v10 offset:22784
    ds_read_b32 v21, v10 offset:22976
    ds_read_b32 v22, v10 offset:23168
    ds_read_b32 v23, v10 offset:23360
    ds_read_b32 v24, v10 offset:23552
    ds_read_b32 v25, v10 offset:23744
    ds_read_b32 v26, v10 offset:23936
    ds_read_b32 v27, v10 offset:24128
    ds_read_b32 v28, v10 offset:24320
    ds_read_b32 v29, v10 offset:24512
    ds_read_b32 v30, v10 offset:24704
    ds_read_b32 v31, v10 offset:24896
    s_waitcnt lgkmcnt(0)
    v_add_f32 v12, v12, v22
    v_add_f32 v13, v13, v23
    v_add_f32 v14, v14, v24
    v_add_f32 v15, v15, v25
    v_add_f32 v16, v16, v26
    v_add_f32 v17, v17, v27
    v_add_f32 v18, v18, v28
    v_add_f32 v19, v19, v29
    v_add_f32 v20, v20, v30
    v_add_f32 v21, v21, v31
    v_add_f32 v12, v12, v17
    v_add_f32 v13, v13, v18
    v_add_f32 v14, v14, v19
    v_add_f32 v15, v15, v20
    v_add_f32 v16, v16, v21
    v_add_f32 v12, v12, v13
    v_add_f32 v12, v12, v14
    v_add_f32 v12, v12, v15
    v_add_f32 v12, v12, v16
    buffer_store_dword v12, v10, s[40:43], s81 offen sc1
L_pub_done:
    s_waitcnt vmcnt(0)
    s_barrier
    s_cmp_lg_u32 s76, 0
    s_cbranch_scc1 L_arr_skip
    s_mov_b32 s82, 1
    s_atomic_add s82, s[86:87], 0x0 glc
L_arr_skip:
    s_add_u32 s81, s88, s83
    s_and_b32 s81, s81, 2047
    s_mul_i32 s81, s81, 6144
    s_cmp_lt_u32 s88, 2048
    s_cselect_b32 s81, s81, 0x7f000000
    buffer_load_dwordx4 v[88:91], v1, s[36:39], s81 offen offset:0 nt
    buffer_load_dwordx4 v[92:95], v1, s[36:39], s81 offen offset:128 nt
    buffer_load_dwordx4 v[96:99], v1, s[36:39], s81 offen offset:256 nt
    buffer_load_dwordx4 v[100:103], v1, s[36:39], s81 offen offset:3072 nt
    buffer_load_dwordx4 v[104:107], v1, s[36:39], s81 offen offset:3200 nt
    buffer_load_dwordx4 v[108:111], v1, s[36:39], s81 offen offset:3328 nt
    s_cmp_lg_u32 s76, 0
    s_cbranch_scc1 L_arr_done
    s_waitcnt lgkmcnt(0)
    s_add_u32 s82, s82, 1
L_arr_poll:
    s_cmp_ge_u32 s82, 8
    s_cbranch_scc1 L_arr_done
    s_mov_b32 s82, 0
    s_atomic_add s82, s[86:87], 0x0 glc
    s_waitcnt lgkmcnt(0)
    s_branch L_arr_poll
L_arr_done:
    s_barrier
    s_cmp_ge_u32 s76, 4
    s_cbranch_scc1 L_pl_skip
    s_lshl_b32 s81, s77, 13
    s_add_u32 s81, s81, 1638400
    buffer_load_dword v204, v10, s[40:43], s81 offen sc1
    s_add_u32 s81, s81, 1024
    buffer_load_dword v205, v10, s[40:43], s81 offen sc1
    s_add_u32 s81, s81, 1024
    buffer_load_dword v206, v10, s[40:43], s81 offen sc1
    s_add_u32 s81, s81, 1024
    buffer_load_dword v207, v10, s[40:43], s81 offen sc1
    s_add_u32 s81, s81, 1024
    buffer_load_dword v208, v10, s[40:43], s81 offen sc1
    s_add_u32 s81, s81, 1024
    buffer_load_dword v209, v10, s[40:43], s81 offen sc1
    s_add_u32 s81, s81, 1024
    buffer_load_dword v210, v10, s[40:43], s81 offen sc1
    s_add_u32 s81, s81, 1024
    buffer_load_dword v211, v10, s[40:43], s81 offen sc1
L_pl_skip:
    s_barrier
    s_add_u32 s81, s89, s83
    s_and_b32 s81, s81, 2047
    s_mul_i32 s81, s81, 6144
    s_cmp_lt_u32 s89, 2048
    s_cselect_b32 s81, s81, 0x7f000000
    buffer_load_dwordx4 v[112:115], v1, s[32:35], s81 offen offset:0 nt
    buffer_load_dwordx4 v[116:119], v1, s[32:35], s81 offen offset:128 nt
    buffer_load_dwordx4 v[120:123], v1, s[32:35], s81 offen offset:256 nt
    buffer_load_dwordx4 v[124:127], v1, s[32:35], s81 offen offset:3072 nt
    buffer_load_dwordx4 v[128:131], v1, s[32:35], s81 offen offset:3200 nt
    buffer_load_dwordx4 v[132:135], v1, s[32:35], s81 offen offset:3328 nt
    buffer_load_dwordx4 v[136:139], v1, s[36:39], s81 offen offset:0 nt
    buffer_load_dwordx4 v[140:143], v1, s[36:39], s81 offen offset:128 nt
    buffer_load_dwordx4 v[144:147], v1, s[36:39], s81 offen offset:256 nt
    buffer_load_dwordx4 v[148:151], v1, s[36:39], s81 offen offset:3072 nt
    buffer_load_dwordx4 v[152:155], v1, s[36:39], s81 offen offset:3200 nt
    buffer_load_dwordx4 v[156:159], v1, s[36:39], s81 offen offset:3328 nt
    s_cmp_ge_u32 s76, 4
    s_cbranch_scc1 L_q_done
    s_waitcnt vmcnt(12)
    v_add_f32 v204, v204, v208
    v_add_f32 v205, v205, v209
    v_add_f32 v206, v206, v210
    v_add_f32 v207, v207, v211
    v_add_f32 v204, v204, v206
    v_add_f32 v205, v205, v207
    v_add_f32 v204, v204, v205
    v_cvt_pk_bf16_f32 v11, v204, v204
    s_cmp_eq_u32 s76, 3
    s_cbranch_scc1 L_q_h
    v_lshlrev_b32 v5, 1, v0
    ds_write_b16 v5, v11 offset:25856
    s_branch L_q_done
L_q_h:
    v_lshlrev_b32 v11, 16, v11
    v_lshlrev_b32 v5, 16, v202
    v_add_f32 v11, v11, v5
    v_cvt_pk_bf16_f32 v5, v11, v11
    v_lshlrev_b32 v11, 16, v5
    v_mul_f32 v5, v11, v11
    v_mov_b32 v8, 1.0
    v_fmac_f32 v8, 0x3d372713, v5
    v_mul_f32 v5, v11, v8
    v_mul_f32 v5, 0xc0135761, v5
    v_exp_f32 v5, v5
    s_nop 0
    v_add_f32 v5, 1.0, v5
    v_rcp_f32 v5, v5
    s_nop 0
    v_mul_f32 v11, v11, v5
    v_cvt_pk_bf16_f32 v5, v11, v11
    v_lshlrev_b32 v11, 16, v5
    ds_write_b32 v10, v11 offset:40192
L_q_done:
    s_waitcnt lgkmcnt(0)
    s_barrier
    ds_read_b128 v[36:39], v7 offset:25856
    ds_read_b128 v[40:43], v7 offset:25984
    ds_read_b128 v[44:47], v7 offset:26112
    v_mov_b32 v12, 0
    v_mov_b32 v13, 0
    v_mov_b32 v14, 0
    v_mov_b32 v15, 0
    v_mov_b32 v16, 0
    v_mov_b32 v17, 0
    v_mov_b32 v18, 0
    v_mov_b32 v19, 0
    v_mov_b32 v20, 0
    v_mov_b32 v21, 0
    v_mov_b32 v22, 0
    v_mov_b32 v23, 0
    v_mov_b32 v24, 0
    v_mov_b32 v25, 0
    v_mov_b32 v26, 0
    v_mov_b32 v27, 0
    v_mov_b32 v28, 0
    v_mov_b32 v29, 0
    v_mov_b32 v30, 0
    v_mov_b32 v31, 0
    v_mov_b32 v32, 0
    v_mov_b32 v33, 0
    v_mov_b32 v34, 0
    v_mov_b32 v35, 0
    v_mov_b32 v3, 0xff800000
    v_mov_b32 v4, 0
    s_setprio 0
    s_waitcnt lgkmcnt(0)
L_loop:
    s_cmp_ge_u32 s88, 2048
    s_cbranch_scc1 L_done
    s_mov_b32 s82, 1
    s_atomic_add s82, s[84:85], 0x0 glc
    s_waitcnt vmcnt(18)
    v_dot2_f32_bf16 v53, v64, v36, 0
    v_dot2_f32_bf16 v54, v76, v36, 0
    v_dot2_f32_bf16 v53, v65, v37, v53
    v_dot2_f32_bf16 v54, v77, v37, v54
    v_dot2_f32_bf16 v53, v66, v38, v53
    v_dot2_f32_bf16 v54, v78, v38, v54
    v_dot2_f32_bf16 v53, v67, v39, v53
    v_dot2_f32_bf16 v54, v79, v39, v54
    v_dot2_f32_bf16 v53, v68, v40, v53
    v_dot2_f32_bf16 v54, v80, v40, v54
    v_dot2_f32_bf16 v53, v69, v41, v53
    v_dot2_f32_bf16 v54, v81, v41, v54
    v_dot2_f32_bf16 v53, v70, v42, v53
    v_dot2_f32_bf16 v54, v82, v42, v54
    v_dot2_f32_bf16 v53, v71, v43, v53
    v_dot2_f32_bf16 v54, v83, v43, v54
    v_dot2_f32_bf16 v53, v72, v44, v53
    v_dot2_f32_bf16 v54, v84, v44, v54
    v_dot2_f32_bf16 v53, v73, v45, v53
    v_dot2_f32_bf16 v54, v85, v45, v54
    v_dot2_f32_bf16 v53, v74, v46, v53
    v_dot2_f32_bf16 v54, v86, v46, v54
    v_dot2_f32_bf16 v53, v75, v47, v53
    v_dot2_f32_bf16 v54, v87, v47, v54
    s_waitcnt lgkmcnt(0)
    s_add_u32 s88, s82, 128
    s_add_u32 s81, s88, s83
    s_and_b32 s81, s81, 2047
    s_mul_i32 s81, s81, 6144
    s_cmp_lt_u32 s88, 2048
    s_cselect_b32 s81, s81, 0x7f000000
    buffer_load_dwordx4 v[64:67], v1, s[32:35], s81 offen offset:0 nt
    buffer_load_dwordx4 v[68:71], v1, s[32:35], s81 offen offset:128 nt
    buffer_load_dwordx4 v[72:75], v1, s[32:35], s81 offen offset:256 nt
    buffer_load_dwordx4 v[76:79], v1, s[32:35], s81 offen offset:3072 nt
    buffer_load_dwordx4 v[80:83], v1, s[32:35], s81 offen offset:3200 nt
    buffer_load_dwordx4 v[84:87], v1, s[32:35], s81 offen offset:3328 nt
    v_add_f32_dpp v53, v53, v53 quad_perm:[1,0,3,2] row_mask:0xf bank_mask:0xf
    v_add_f32_dpp v54, v54, v54 quad_perm:[1,0,3,2] row_mask:0xf bank_mask:0xf
    s_nop 0
    v_add_f32_dpp v53, v53, v53 quad_perm:[2,3,0,1] row_mask:0xf bank_mask:0xf
    v_add_f32_dpp v54, v54, v54 quad_perm:[2,3,0,1] row_mask:0xf bank_mask:0xf
    s_nop 0
    v_add_f32_dpp v53, v53, v53 row_half_mirror row_mask:0xf bank_mask:0xf
    v_add_f32_dpp v54, v54, v54 row_half_mirror row_mask:0xf bank_mask:0xf
    s_nop 0
    v_cvt_pk_bf16_f32 v8, v53, v54
    v_lshlrev_b32 v53, 16, v8
    v_and_b32 v54, 0xffff0000, v8
    v_mul_f32 v53, s92, v53
    v_mul_f32 v54, s92, v54
    v_cvt_pk_bf16_f32 v8, v53, v54
    v_lshlrev_b32 v53, 16, v8
    v_and_b32 v54, 0xffff0000, v8
    v_mul_f32 v53, s91, v53
    v_mul_f32 v54, s91, v54
    v_max3_f32 v8, v3, v53, v54
    v_sub_f32 v9, v3, v8
    v_sub_f32 v53, v53, v8
    v_sub_f32 v54, v54, v8
    v_exp_f32 v9, v9
    v_exp_f32 v53, v53
    v_exp_f32 v54, v54
    v_mov_b32 v3, v8
    v_fma_f32 v4, v4, v9, v53
    v_add_f32 v4, v4, v54
    v_mul_f32 v12, v12, v9
    v_mul_f32 v13, v13, v9
    v_mul_f32 v14, v14, v9
    v_mul_f32 v15, v15, v9
    v_mul_f32 v16, v16, v9
    v_mul_f32 v17, v17, v9
    v_mul_f32 v18, v18, v9
    v_mul_f32 v19, v19, v9
    v_mul_f32 v20, v20, v9
    v_mul_f32 v21, v21, v9
    v_mul_f32 v22, v22, v9
    v_mul_f32 v23, v23, v9
    v_mul_f32 v24, v24, v9
    v_mul_f32 v25, v25, v9
    v_mul_f32 v26, v26, v9
    v_mul_f32 v27, v27, v9
    v_mul_f32 v28, v28, v9
    v_mul_f32 v29, v29, v9
    v_mul_f32 v30, v30, v9
    v_mul_f32 v31, v31, v9
    v_mul_f32 v32, v32, v9
    v_mul_f32 v33, v33, v9
    v_mul_f32 v34, v34, v9
    v_mul_f32 v35, v35, v9
    s_waitcnt vmcnt(18)
    v_lshlrev_b32 v58, 16, v88
    v_and_b32 v59, s90, v88
    v_fmac_f32 v12, v53, v58
    v_fmac_f32 v13, v53, v59
    v_lshlrev_b32 v60, 16, v89
    v_and_b32 v61, s90, v89
    v_fmac_f32 v14, v53, v60
    v_fmac_f32 v15, v53, v61
    v_lshlrev_b32 v62, 16, v90
    v_and_b32 v63, s90, v90
    v_fmac_f32 v16, v53, v62
    v_fmac_f32 v17, v53, v63
    v_lshlrev_b32 v58, 16, v91
    v_and_b32 v59, s90, v91
    v_fmac_f32 v18, v53, v58
    v_fmac_f32 v19, v53, v59
    v_lshlrev_b32 v60, 16, v92
    v_and_b32 v61, s90, v92
    v_fmac_f32 v20, v53, v60
    v_fmac_f32 v21, v53, v61
    v_lshlrev_b32 v62, 16, v93
    v_and_b32 v63, s90, v93
    v_fmac_f32 v22, v53, v62
    v_fmac_f32 v23, v53, v63
    v_lshlrev_b32 v58, 16, v94
    v_and_b32 v59, s90, v94
    v_fmac_f32 v24, v53, v58
    v_fmac_f32 v25, v53, v59
    v_lshlrev_b32 v60, 16, v95
    v_and_b32 v61, s90, v95
    v_fmac_f32 v26, v53, v60
    v_fmac_f32 v27, v53, v61
    v_lshlrev_b32 v62, 16, v96
    v_and_b32 v63, s90, v96
    v_fmac_f32 v28, v53, v62
    v_fmac_f32 v29, v53, v63
    v_lshlrev_b32 v58, 16, v97
    v_and_b32 v59, s90, v97
    v_fmac_f32 v30, v53, v58
    v_fmac_f32 v31, v53, v59
    v_lshlrev_b32 v60, 16, v98
    v_and_b32 v61, s90, v98
    v_fmac_f32 v32, v53, v60
    v_fmac_f32 v33, v53, v61
    v_lshlrev_b32 v62, 16, v99
    v_and_b32 v63, s90, v99
    v_fmac_f32 v34, v53, v62
    v_fmac_f32 v35, v53, v63
    v_lshlrev_b32 v58, 16, v100
    v_and_b32 v59, s90, v100
    v_fmac_f32 v12, v54, v58
    v_fmac_f32 v13, v54, v59
    v_lshlrev_b32 v60, 16, v101
    v_and_b32 v61, s90, v101
    v_fmac_f32 v14, v54, v60
    v_fmac_f32 v15, v54, v61
    v_lshlrev_b32 v62, 16, v102
    v_and_b32 v63, s90, v102
    v_fmac_f32 v16, v54, v62
    v_fmac_f32 v17, v54, v63
    v_lshlrev_b32 v58, 16, v103
    v_and_b32 v59, s90, v103
    v_fmac_f32 v18, v54, v58
    v_fmac_f32 v19, v54, v59
    v_lshlrev_b32 v60, 16, v104
    v_and_b32 v61, s90, v104
    v_fmac_f32 v20, v54, v60
    v_fmac_f32 v21, v54, v61
    v_lshlrev_b32 v62, 16, v105
    v_and_b32 v63, s90, v105
    v_fmac_f32 v22, v54, v62
    v_fmac_f32 v23, v54, v63
    v_lshlrev_b32 v58, 16, v106
    v_and_b32 v59, s90, v106
    v_fmac_f32 v24, v54, v58
    v_fmac_f32 v25, v54, v59
    v_lshlrev_b32 v60, 16, v107
    v_and_b32 v61, s90, v107
    v_fmac_f32 v26, v54, v60
    v_fmac_f32 v27, v54, v61
    v_lshlrev_b32 v62, 16, v108
    v_and_b32 v63, s90, v108
    v_fmac_f32 v28, v54, v62
    v_fmac_f32 v29, v54, v63
    v_lshlrev_b32 v58, 16, v109
    v_and_b32 v59, s90, v109
    v_fmac_f32 v30, v54, v58
    v_fmac_f32 v31, v54, v59
    v_lshlrev_b32 v60, 16, v110
    v_and_b32 v61, s90, v110
    v_fmac_f32 v32, v54, v60
    v_fmac_f32 v33, v54, v61
    v_lshlrev_b32 v62, 16, v111
    v_and_b32 v63, s90, v111
    v_fmac_f32 v34, v54, v62
    v_fmac_f32 v35, v54, v63
    buffer_load_dwordx4 v[88:91], v1, s[36:39], s81 offen offset:0 nt
    buffer_load_dwordx4 v[92:95], v1, s[36:39], s81 offen offset:128 nt
    buffer_load_dwordx4 v[96:99], v1, s[36:39], s81 offen offset:256 nt
    buffer_load_dwordx4 v[100:103], v1, s[36:39], s81 offen offset:3072 nt
    buffer_load_dwordx4 v[104:107], v1, s[36:39], s81 offen offset:3200 nt
    buffer_load_dwordx4 v[108:111], v1, s[36:39], s81 offen offset:3328 nt
    s_cmp_ge_u32 s89, 2048
    s_cbranch_scc1 L_done
    s_mov_b32 s82, 1
    s_atomic_add s82, s[84:85], 0x0 glc
    s_waitcnt vmcnt(18)
    v_dot2_f32_bf16 v53, v112, v36, 0
    v_dot2_f32_bf16 v54, v124, v36, 0
    v_dot2_f32_bf16 v53, v113, v37, v53
    v_dot2_f32_bf16 v54, v125, v37, v54
    v_dot2_f32_bf16 v53, v114, v38, v53
    v_dot2_f32_bf16 v54, v126, v38, v54
    v_dot2_f32_bf16 v53, v115, v39, v53
    v_dot2_f32_bf16 v54, v127, v39, v54
    v_dot2_f32_bf16 v53, v116, v40, v53
    v_dot2_f32_bf16 v54, v128, v40, v54
    v_dot2_f32_bf16 v53, v117, v41, v53
    v_dot2_f32_bf16 v54, v129, v41, v54
    v_dot2_f32_bf16 v53, v118, v42, v53
    v_dot2_f32_bf16 v54, v130, v42, v54
    v_dot2_f32_bf16 v53, v119, v43, v53
    v_dot2_f32_bf16 v54, v131, v43, v54
    v_dot2_f32_bf16 v53, v120, v44, v53
    v_dot2_f32_bf16 v54, v132, v44, v54
    v_dot2_f32_bf16 v53, v121, v45, v53
    v_dot2_f32_bf16 v54, v133, v45, v54
    v_dot2_f32_bf16 v53, v122, v46, v53
    v_dot2_f32_bf16 v54, v134, v46, v54
    v_dot2_f32_bf16 v53, v123, v47, v53
    v_dot2_f32_bf16 v54, v135, v47, v54
    s_waitcnt lgkmcnt(0)
    s_add_u32 s89, s82, 128
    s_add_u32 s81, s89, s83
    s_and_b32 s81, s81, 2047
    s_mul_i32 s81, s81, 6144
    s_cmp_lt_u32 s89, 2048
    s_cselect_b32 s81, s81, 0x7f000000
    buffer_load_dwordx4 v[112:115], v1, s[32:35], s81 offen offset:0 nt
    buffer_load_dwordx4 v[116:119], v1, s[32:35], s81 offen offset:128 nt
    buffer_load_dwordx4 v[120:123], v1, s[32:35], s81 offen offset:256 nt
    buffer_load_dwordx4 v[124:127], v1, s[32:35], s81 offen offset:3072 nt
    buffer_load_dwordx4 v[128:131], v1, s[32:35], s81 offen offset:3200 nt
    buffer_load_dwordx4 v[132:135], v1, s[32:35], s81 offen offset:3328 nt
    v_add_f32_dpp v53, v53, v53 quad_perm:[1,0,3,2] row_mask:0xf bank_mask:0xf
    v_add_f32_dpp v54, v54, v54 quad_perm:[1,0,3,2] row_mask:0xf bank_mask:0xf
    s_nop 0
    v_add_f32_dpp v53, v53, v53 quad_perm:[2,3,0,1] row_mask:0xf bank_mask:0xf
    v_add_f32_dpp v54, v54, v54 quad_perm:[2,3,0,1] row_mask:0xf bank_mask:0xf
    s_nop 0
    v_add_f32_dpp v53, v53, v53 row_half_mirror row_mask:0xf bank_mask:0xf
    v_add_f32_dpp v54, v54, v54 row_half_mirror row_mask:0xf bank_mask:0xf
    s_nop 0
    v_cvt_pk_bf16_f32 v8, v53, v54
    v_lshlrev_b32 v53, 16, v8
    v_and_b32 v54, 0xffff0000, v8
    v_mul_f32 v53, s92, v53
    v_mul_f32 v54, s92, v54
    v_cvt_pk_bf16_f32 v8, v53, v54
    v_lshlrev_b32 v53, 16, v8
    v_and_b32 v54, 0xffff0000, v8
    v_mul_f32 v53, s91, v53
    v_mul_f32 v54, s91, v54
    v_max3_f32 v8, v3, v53, v54
    v_sub_f32 v9, v3, v8
    v_sub_f32 v53, v53, v8
    v_sub_f32 v54, v54, v8
    v_exp_f32 v9, v9
    v_exp_f32 v53, v53
    v_exp_f32 v54, v54
    v_mov_b32 v3, v8
    v_fma_f32 v4, v4, v9, v53
    v_add_f32 v4, v4, v54
    v_mul_f32 v12, v12, v9
    v_mul_f32 v13, v13, v9
    v_mul_f32 v14, v14, v9
    v_mul_f32 v15, v15, v9
    v_mul_f32 v16, v16, v9
    v_mul_f32 v17, v17, v9
    v_mul_f32 v18, v18, v9
    v_mul_f32 v19, v19, v9
    v_mul_f32 v20, v20, v9
    v_mul_f32 v21, v21, v9
    v_mul_f32 v22, v22, v9
    v_mul_f32 v23, v23, v9
    v_mul_f32 v24, v24, v9
    v_mul_f32 v25, v25, v9
    v_mul_f32 v26, v26, v9
    v_mul_f32 v27, v27, v9
    v_mul_f32 v28, v28, v9
    v_mul_f32 v29, v29, v9
    v_mul_f32 v30, v30, v9
    v_mul_f32 v31, v31, v9
    v_mul_f32 v32, v32, v9
    v_mul_f32 v33, v33, v9
    v_mul_f32 v34, v34, v9
    v_mul_f32 v35, v35, v9
    s_waitcnt vmcnt(18)
    v_lshlrev_b32 v58, 16, v136
    v_and_b32 v59, s90, v136
    v_fmac_f32 v12, v53, v58
    v_fmac_f32 v13, v53, v59
    v_lshlrev_b32 v60, 16, v137
    v_and_b32 v61, s90, v137
    v_fmac_f32 v14, v53, v60
    v_fmac_f32 v15, v53, v61
    v_lshlrev_b32 v62, 16, v138
    v_and_b32 v63, s90, v138
    v_fmac_f32 v16, v53, v62
    v_fmac_f32 v17, v53, v63
    v_lshlrev_b32 v58, 16, v139
    v_and_b32 v59, s90, v139
    v_fmac_f32 v18, v53, v58
    v_fmac_f32 v19, v53, v59
    v_lshlrev_b32 v60, 16, v140
    v_and_b32 v61, s90, v140
    v_fmac_f32 v20, v53, v60
    v_fmac_f32 v21, v53, v61
    v_lshlrev_b32 v62, 16, v141
    v_and_b32 v63, s90, v141
    v_fmac_f32 v22, v53, v62
    v_fmac_f32 v23, v53, v63
    v_lshlrev_b32 v58, 16, v142
    v_and_b32 v59, s90, v142
    v_fmac_f32 v24, v53, v58
    v_fmac_f32 v25, v53, v59
    v_lshlrev_b32 v60, 16, v143
    v_and_b32 v61, s90, v143
    v_fmac_f32 v26, v53, v60
    v_fmac_f32 v27, v53, v61
    v_lshlrev_b32 v62, 16, v144
    v_and_b32 v63, s90, v144
    v_fmac_f32 v28, v53, v62
    v_fmac_f32 v29, v53, v63
    v_lshlrev_b32 v58, 16, v145
    v_and_b32 v59, s90, v145
    v_fmac_f32 v30, v53, v58
    v_fmac_f32 v31, v53, v59
    v_lshlrev_b32 v60, 16, v146
    v_and_b32 v61, s90, v146
    v_fmac_f32 v32, v53, v60
    v_fmac_f32 v33, v53, v61
    v_lshlrev_b32 v62, 16, v147
    v_and_b32 v63, s90, v147
    v_fmac_f32 v34, v53, v62
    v_fmac_f32 v35, v53, v63
    v_lshlrev_b32 v58, 16, v148
    v_and_b32 v59, s90, v148
    v_fmac_f32 v12, v54, v58
    v_fmac_f32 v13, v54, v59
    v_lshlrev_b32 v60, 16, v149
    v_and_b32 v61, s90, v149
    v_fmac_f32 v14, v54, v60
    v_fmac_f32 v15, v54, v61
    v_lshlrev_b32 v62, 16, v150
    v_and_b32 v63, s90, v150
    v_fmac_f32 v16, v54, v62
    v_fmac_f32 v17, v54, v63
    v_lshlrev_b32 v58, 16, v151
    v_and_b32 v59, s90, v151
    v_fmac_f32 v18, v54, v58
    v_fmac_f32 v19, v54, v59
    v_lshlrev_b32 v60, 16, v152
    v_and_b32 v61, s90, v152
    v_fmac_f32 v20, v54, v60
    v_fmac_f32 v21, v54, v61
    v_lshlrev_b32 v62, 16, v153
    v_and_b32 v63, s90, v153
    v_fmac_f32 v22, v54, v62
    v_fmac_f32 v23, v54, v63
    v_lshlrev_b32 v58, 16, v154
    v_and_b32 v59, s90, v154
    v_fmac_f32 v24, v54, v58
    v_fmac_f32 v25, v54, v59
    v_lshlrev_b32 v60, 16, v155
    v_and_b32 v61, s90, v155
    v_fmac_f32 v26, v54, v60
    v_fmac_f32 v27, v54, v61
    v_lshlrev_b32 v62, 16, v156
    v_and_b32 v63, s90, v156
    v_fmac_f32 v28, v54, v62
    v_fmac_f32 v29, v54, v63
    v_lshlrev_b32 v58, 16, v157
    v_and_b32 v59, s90, v157
    v_fmac_f32 v30, v54, v58
    v_fmac_f32 v31, v54, v59
    v_lshlrev_b32 v60, 16, v158
    v_and_b32 v61, s90, v158
    v_fmac_f32 v32, v54, v60
    v_fmac_f32 v33, v54, v61
    v_lshlrev_b32 v62, 16, v159
    v_and_b32 v63, s90, v159
    v_fmac_f32 v34, v54, v62
    v_fmac_f32 v35, v54, v63
    buffer_load_dwordx4 v[136:139], v1, s[36:39], s81 offen offset:0 nt
    buffer_load_dwordx4 v[140:143], v1, s[36:39], s81 offen offset:128 nt
    buffer_load_dwordx4 v[144:147], v1, s[36:39], s81 offen offset:256 nt
    buffer_load_dwordx4 v[148:151], v1, s[36:39], s81 offen offset:3072 nt
    buffer_load_dwordx4 v[152:155], v1, s[36:39], s81 offen offset:3200 nt
    buffer_load_dwordx4 v[156:159], v1, s[36:39], s81 offen offset:3328 nt
    s_branch L_loop
L_done:
    v_mul_u32_u24 v184, 3277, v0
    v_lshrrev_b32 v184, 18, v184
    v_mul_u32_u24 v185, 80, v184
    v_sub_u32 v185, v0, v185
    v_mul_u32_u24 v10, 5120, v184
    v_lshl_add_u32 v10, v185, 4, v10
    s_mul_i32 s79, s2, 30720
    buffer_load_dwordx4 v[160:163], v10, s[52:55], s79 offen offset:0 nt
    buffer_load_dwordx4 v[164:167], v10, s[52:55], s79 offen offset:1280 nt
    buffer_load_dwordx4 v[168:171], v10, s[52:55], s79 offen offset:2560 nt
    buffer_load_dwordx4 v[172:175], v10, s[52:55], s79 offen offset:3840 nt
    v_mul_u32_u24 v10, 1280, v184
    v_lshl_add_u32 v10, v185, 4, v10
    s_mul_i32 s79, s2, 7680
    buffer_load_dwordx4 v[176:179], v10, s[56:59], s79 offen nt
    v_mov_b32 v6, v3
    s_nop 1
    v_max_f32_dpp v6, v6, v6 row_ror:8 row_mask:0xf bank_mask:0xf
    s_nop 1
    v_mov_b32 v7, v6
    s_nop 1
    v_permlane16_swap_b32 v6, v7
    v_max_f32 v6, v6, v7
    s_nop 1
    v_mov_b32 v7, v6
    s_nop 1
    v_permlane32_swap_b32 v6, v7
    v_max_f32 v6, v6, v7
    v_sub_f32 v7, v3, v6
    v_exp_f32 v7, v7
    s_nop 0
    v_mul_f32 v12, v12, v7
    v_mul_f32 v13, v13, v7
    v_mul_f32 v14, v14, v7
    v_mul_f32 v15, v15, v7
    v_mul_f32 v16, v16, v7
    v_mul_f32 v17, v17, v7
    v_mul_f32 v18, v18, v7
    v_mul_f32 v19, v19, v7
    v_mul_f32 v20, v20, v7
    v_mul_f32 v21, v21, v7
    v_mul_f32 v22, v22, v7
    v_mul_f32 v23, v23, v7
    v_mul_f32 v24, v24, v7
    v_mul_f32 v25, v25, v7
    v_mul_f32 v26, v26, v7
    v_mul_f32 v27, v27, v7
    v_mul_f32 v28, v28, v7
    v_mul_f32 v29, v29, v7
    v_mul_f32 v30, v30, v7
    v_mul_f32 v31, v31, v7
    v_mul_f32 v32, v32, v7
    v_mul_f32 v33, v33, v7
    v_mul_f32 v34, v34, v7
    v_mul_f32 v35, v35, v7
    v_mul_f32 v7, v4, v7
    s_nop 1
    v_add_f32_dpp v7, v7, v7 row_ror:8 row_mask:0xf bank_mask:0xf
    s_nop 1
    v_mov_b32 v8, v7
    s_nop 1
    v_permlane16_swap_b32 v7, v8
    v_add_f32 v7, v7, v8
    s_nop 1
    v_mov_b32 v8, v7
    s_nop 1
    v_permlane32_swap_b32 v7, v8
    v_add_f32 v7, v7, v8
    s_nop 1
    v_permlane32_swap_b32 v12, v24
    v_permlane32_swap_b32 v13, v25
    v_permlane32_swap_b32 v14, v26
    v_permlane32_swap_b32 v15, v27
    v_permlane32_swap_b32 v16, v28
    v_permlane32_swap_b32 v17, v29
    v_permlane32_swap_b32 v18, v30
    v_permlane32_swap_b32 v19, v31
    v_permlane32_swap_b32 v20, v32
    v_permlane32_swap_b32 v21, v33
    v_permlane32_swap_b32 v22, v34
    v_permlane32_swap_b32 v23, v35
    v_add_f32 v12, v12, v24
    v_add_f32 v13, v13, v25
    v_add_f32 v14, v14, v26
    v_add_f32 v15, v15, v27
    v_add_f32 v16, v16, v28
    v_add_f32 v17, v17, v29
    v_add_f32 v18, v18, v30
    v_add_f32 v19, v19, v31
    v_add_f32 v20, v20, v32
    v_add_f32 v21, v21, v33
    v_add_f32 v22, v22, v34
    v_add_f32 v23, v23, v35
    s_nop 1
    v_permlane16_swap_b32 v12, v18
    v_permlane16_swap_b32 v13, v19
    v_permlane16_swap_b32 v14, v20
    v_permlane16_swap_b32 v15, v21
    v_permlane16_swap_b32 v16, v22
    v_permlane16_swap_b32 v17, v23
    v_add_f32 v12, v12, v18
    v_add_f32 v13, v13, v19
    v_add_f32 v14, v14, v20
    v_add_f32 v15, v15, v21
    v_add_f32 v16, v16, v22
    v_add_f32 v17, v17, v23
    s_nop 1
    v_add_f32_dpp v12, v12, v12 row_ror:8 row_mask:0xf bank_mask:0xf
    v_add_f32_dpp v13, v13, v13 row_ror:8 row_mask:0xf bank_mask:0xf
    v_add_f32_dpp v14, v14, v14 row_ror:8 row_mask:0xf bank_mask:0xf
    v_add_f32_dpp v15, v15, v15 row_ror:8 row_mask:0xf bank_mask:0xf
    v_add_f32_dpp v16, v16, v16 row_ror:8 row_mask:0xf bank_mask:0xf
    v_add_f32_dpp v17, v17, v17 row_ror:8 row_mask:0xf bank_mask:0xf
    s_mul_i32 s79, s76, 800
    v_and_b32 v10, 7, v2
    v_mul_u32_u24 v10, 96, v10
    v_lshrrev_b32 v11, 4, v2
    v_mul_u32_u24 v5, 24, v11
    v_add3_u32 v10, v10, v5, s79
    ds_write_b64 v10, v[12:13] offset:0
    ds_write_b64 v10, v[14:15] offset:8
    ds_write_b64 v10, v[16:17] offset:16
    s_lshl_b32 s79, s76, 3
    v_mov_b32 v11, s79
    ds_write_b64 v11, v[6:7] offset:6400
    s_waitcnt lgkmcnt(0)
    s_barrier
    s_cmp_ge_u32 s76, 3
    s_cbranch_scc1 L_join1
    ds_read_b128 v[12:15], v52 offset:6400
    ds_read_b128 v[16:19], v52 offset:6416
    ds_read_b128 v[20:23], v52 offset:6432
    ds_read_b128 v[24:27], v52 offset:6448
    v_lshlrev_b32 v10, 2, v0
    ds_read_b32 v28, v10 offset:0
    ds_read_b32 v29, v10 offset:800
    ds_read_b32 v30, v10 offset:1600
    ds_read_b32 v31, v10 offset:2400
    ds_read_b32 v32, v10 offset:3200
    ds_read_b32 v33, v10 offset:4000
    ds_read_b32 v34, v10 offset:4800
    ds_read_b32 v35, v10 offset:5600
    v_mul_u32_u24 v11, 2731, v0
    v_lshrrev_b32 v11, 16, v11
    v_mul_u32_u24 v5, 24, v11
    v_sub_u32 v5, v0, v5
    v_lshrrev_b32 v8, 3, v5
    v_lshlrev_b32 v8, 6, v8
    v_and_b32 v5, 7, v5
    v_lshlrev_b32 v11, 3, v11
    v_add3_u32 v8, v8, v11, v5
    v_lshlrev_b32 v8, 2, v8
    s_waitcnt lgkmcnt(0)
    v_max3_f32 v6, v12, v14, v16
    v_max3_f32 v6, v6, v18, v20
    v_max3_f32 v6, v6, v22, v24
    v_max_f32 v6, v6, v26
    v_sub_f32 v12, v12, v6
    v_sub_f32 v14, v14, v6
    v_sub_f32 v16, v16, v6
    v_sub_f32 v18, v18, v6
    v_sub_f32 v20, v20, v6
    v_sub_f32 v22, v22, v6
    v_sub_f32 v24, v24, v6
    v_sub_f32 v26, v26, v6
    v_exp_f32 v12, v12
    v_exp_f32 v14, v14
    v_exp_f32 v16, v16
    v_exp_f32 v18, v18
    v_exp_f32 v20, v20
    v_exp_f32 v22, v22
    v_exp_f32 v24, v24
    v_exp_f32 v26, v26
    s_nop 0
    v_mul_f32 v7, v12, v13
    v_mul_f32 v9, v12, v28
    v_fmac_f32 v7, v14, v15
    v_fmac_f32 v9, v14, v29
    v_fmac_f32 v7, v16, v17
    v_fmac_f32 v9, v16, v30
    v_fmac_f32 v7, v18, v19
    v_fmac_f32 v9, v18, v31
    v_fmac_f32 v7, v20, v21
    v_fmac_f32 v9, v20, v32
    v_fmac_f32 v7, v22, v23
    v_fmac_f32 v9, v22, v33
    v_fmac_f32 v7, v24, v25
    v_fmac_f32 v9, v24, v34
    v_fmac_f32 v7, v26, v27
    v_fmac_f32 v9, v26, v35
    s_lshl_b32 s79, s2, 10
    s_add_u32 s79, s79, 65536
    v_min_u32 v9, -2, v9
    v_min_u32 v6, -2, v6
    v_min_u32 v7, -2, v7
    buffer_store_dword v9, v8, s[40:43], s79 offen sc1
    s_cmp_eq_u32 s76, 1
    s_cbranch_scc1 L_dbgchk
    s_cmp_lg_u32 s76, 0
    s_cbranch_scc1 L_join1
    s_mov_b64 exec, 1
    buffer_store_dwordx2 v[6:7], v52, s[40:43], s79 offen offset:768 sc1
    s_mov_b64 exec, -1
    s_lshl_b32 s79, s77, 13
    s_add_u32 s79, s79, 65536
    v_min_u32 v10, 23, v0
    s_mul_i32 s80, s78, 24
    v_add_u32 v10, s80, v10
    v_lshlrev_b32 v10, 2, v10
L_poll1:
    s_mov_b32 s80, s79
    buffer_load_dword v192, v10, s[40:43], s80 offen sc1
    buffer_load_dwordx2 v[200:201], v52, s[40:43], s80 offen offset:768 sc1
    s_add_u32 s80, s80, 1024
    buffer_load_dword v193, v10, s[40:43], s80 offen sc1
    buffer_load_dwordx2 v[202:203], v52, s[40:43], s80 offen offset:768 sc1
    s_add_u32 s80, s80, 1024
    buffer_load_dword v194, v10, s[40:43], s80 offen sc1
    buffer_load_dwordx2 v[204:205], v52, s[40:43], s80 offen offset:768 sc1
    s_add_u32 s80, s80, 1024
    buffer_load_dword v195, v10, s[40:43], s80 offen sc1
    buffer_load_dwordx2 v[206:207], v52, s[40:43], s80 offen offset:768 sc1
    s_add_u32 s80, s80, 1024
    buffer_load_dword v196, v10, s[40:43], s80 offen sc1
    buffer_load_dwordx2 v[208:209], v52, s[40:43], s80 offen offset:768 sc1
    s_add_u32 s80, s80, 1024
    buffer_load_dword v197, v10, s[40:43], s80 offen sc1
    buffer_load_dwordx2 v[210:211], v52, s[40:43], s80 offen offset:768 sc1
    s_add_u32 s80, s80, 1024
    buffer_load_dword v198, v10, s[40:43], s80 offen sc1
    buffer_load_dwordx2 v[212:213], v52, s[40:43], s80 offen offset:768 sc1
    s_add_u32 s80, s80, 1024
    buffer_load_dword v199, v10, s[40:43], s80 offen sc1
    buffer_load_dwordx2 v[214:215], v52, s[40:43], s80 offen offset:768 sc1
    s_waitcnt vmcnt(0)
    v_max3_u32 v6, v192, v193, v194
    v_max3_u32 v6, v6, v195, v196
    v_max3_u32 v6, v6, v197, v198
    v_max3_u32 v6, v6, v199, v200
    v_max3_u32 v6, v6, v201, v202
    v_max3_u32 v6, v6, v203, v204
    v_max3_u32 v6, v6, v205, v206
    v_max3_u32 v6, v6, v207, v208
    v_max3_u32 v6, v6, v209, v210
    v_max3_u32 v6, v6, v211, v212
    v_max3_u32 v6, v6, v213, v214
    v_max_u32 v6, v6, v215
    v_cmp_eq_u32 vcc, -1, v6
    s_nop 4
    s_cbranch_vccz L_poll1_done
    s_sleep 1
    s_branch L_poll1
L_poll1_done:
    v_max3_f32 v6, v200, v202, v204
    v_max3_f32 v6, v6, v206, v208
    v_max3_f32 v6, v6, v210, v212
    v_max_f32 v6, v6, v214
    v_sub_f32 v200, v200, v6
    v_sub_f32 v202, v202, v6
    v_sub_f32 v204, v204, v6
    v_sub_f32 v206, v206, v6
    v_sub_f32 v208, v208, v6
    v_sub_f32 v210, v210, v6
    v_sub_f32 v212, v212, v6
    v_sub_f32 v214, v214, v6
    v_exp_f32 v200, v200
    v_exp_f32 v202, v202
    v_exp_f32 v204, v204
    v_exp_f32 v206, v206
    v_exp_f32 v208, v208
    v_exp_f32 v210, v210
    v_exp_f32 v212, v212
    v_exp_f32 v214, v214
    s_nop 0
    v_mul_f32 v7, v200, v201
    v_mul_f32 v8, v200, v192
    v_fmac_f32 v7, v202, v203
    v_fmac_f32 v8, v202, v193
    v_fmac_f32 v7, v204, v205
    v_fmac_f32 v8, v204, v194
    v_fmac_f32 v7, v206, v207
    v_fmac_f32 v8, v206, v195
    v_fmac_f32 v7, v208, v209
    v_fmac_f32 v8, v208, v196
    v_fmac_f32 v7, v210, v211
    v_fmac_f32 v8, v210, v197
    v_fmac_f32 v7, v212, v213
    v_fmac_f32 v8, v212, v198
    v_fmac_f32 v7, v214, v215
    v_fmac_f32 v8, v214, v199
    v_rcp_f32 v9, v7
    s_nop 0
    v_mul_f32 v11, v8, v9
    v_fma_f32 v5, -v11, v7, v8
    v_fma_f32 v11, v5, v9, v11
    v_cvt_pk_bf16_f32 v5, v11, v11
    v_lshlrev_b32 v11, 16, v5
    v_lshlrev_b32 v10, 2, v0
    ds_write_b32 v10, v11 offset:7168
    s_branch L_join1
L_dbgchk:
    s_cmp_ge_u32 s2, 40
    s_cbranch_scc1 L_join1
    v_and_b32 v5, 31, v0
    v_lshlrev_b32 v5, 2, v5
L_dbgpoll:
    buffer_load_dword v192, v5, s[72:75], 0 offen sc1
    s_waitcnt vmcnt(0)
    v_cmp_ne_u32 vcc, 8, v192
    s_nop 4
    s_cbranch_vccz L_join1
    s_sleep 1
    s_branch L_dbgpoll
L_join1:
    s_waitcnt vmcnt(0) lgkmcnt(0)
    s_barrier
    v_lshlrev_b32 v10, 4, v184
    ds_read_b128 v[64:67], v10 offset:7168
    s_mul_i32 s79, s78, 24
    v_lshl_add_u32 v10, v184, 2, s79
    ds_read_b32 v70, v10 offset:40960
    s_waitcnt lgkmcnt(0)
    v_lshlrev_b32 v58, 16, v176
    v_and_b32 v59, s90, v176
    v_mul_f32 v80, v70, v58
    v_mul_f32 v81, v70, v59
    v_lshlrev_b32 v58, 16, v177
    v_and_b32 v59, s90, v177
    v_mul_f32 v82, v70, v58
    v_mul_f32 v83, v70, v59
    v_lshlrev_b32 v58, 16, v178
    v_and_b32 v59, s90, v178
    v_mul_f32 v84, v70, v58
    v_mul_f32 v85, v70, v59
    v_lshlrev_b32 v58, 16, v179
    v_and_b32 v59, s90, v179
    v_mul_f32 v86, v70, v58
    v_mul_f32 v87, v70, v59
    v_lshlrev_b32 v58, 16, v160
    v_and_b32 v59, s90, v160
    v_mul_f32 v72, v64, v58
    v_mul_f32 v73, v64, v59
    v_lshlrev_b32 v58, 16, v161
    v_and_b32 v59, s90, v161
    v_mul_f32 v74, v64, v58
    v_mul_f32 v75, v64, v59
    v_lshlrev_b32 v58, 16, v162
    v_and_b32 v59, s90, v162
    v_mul_f32 v76, v64, v58
    v_mul_f32 v77, v64, v59
    v_lshlrev_b32 v58, 16, v163
    v_and_b32 v59, s90, v163
    v_mul_f32 v78, v64, v58
    v_mul_f32 v79, v64, v59
    v_lshlrev_b32 v58, 16, v164
    v_and_b32 v59, s90, v164
    v_fmac_f32 v72, v65, v58
    v_fmac_f32 v73, v65, v59
    v_lshlrev_b32 v58, 16, v165
    v_and_b32 v59, s90, v165
    v_fmac_f32 v74, v65, v58
    v_fmac_f32 v75, v65, v59
    v_lshlrev_b32 v58, 16, v166
    v_and_b32 v59, s90, v166
    v_fmac_f32 v76, v65, v58
    v_fmac_f32 v77, v65, v59
    v_lshlrev_b32 v58, 16, v167
    v_and_b32 v59, s90, v167
    v_fmac_f32 v78, v65, v58
    v_fmac_f32 v79, v65, v59
    v_lshlrev_b32 v58, 16, v168
    v_and_b32 v59, s90, v168
    v_fmac_f32 v72, v66, v58
    v_fmac_f32 v73, v66, v59
    v_lshlrev_b32 v58, 16, v169
    v_and_b32 v59, s90, v169
    v_fmac_f32 v74, v66, v58
    v_fmac_f32 v75, v66, v59
    v_lshlrev_b32 v58, 16, v170
    v_and_b32 v59, s90, v170
    v_fmac_f32 v76, v66, v58
    v_fmac_f32 v77, v66, v59
    v_lshlrev_b32 v58, 16, v171
    v_and_b32 v59, s90, v171
    v_fmac_f32 v78, v66, v58
    v_fmac_f32 v79, v66, v59
    v_lshlrev_b32 v58, 16, v172
    v_and_b32 v59, s90, v172
    v_fmac_f32 v72, v67, v58
    v_fmac_f32 v73, v67, v59
    v_lshlrev_b32 v58, 16, v173
    v_and_b32 v59, s90, v173
    v_fmac_f32 v74, v67, v58
    v_fmac_f32 v75, v67, v59
    v_lshlrev_b32 v58, 16, v174
    v_and_b32 v59, s90, v174
    v_fmac_f32 v76, v67, v58
    v_fmac_f32 v77, v67, v59
    v_lshlrev_b32 v58, 16, v175
    v_and_b32 v59, s90, v175
    v_fmac_f32 v78, v67, v58
    v_fmac_f32 v79, v67, v59
    v_mul_u32_u24 v8, 2560, v184
    v_lshl_add_u32 v8, v185, 5, v8
    v_cmp_gt_u32 vcc, 480, v0
    s_and_saveexec_b64 s[94:95], vcc
    ds_write_b128 v8, v[72:75] offset:8192
    ds_write_b128 v8, v[76:79] offset:8208
    ds_write_b128 v8, v[80:83] offset:23552
    ds_write_b128 v8, v[84:87] offset:23568
    s_mov_b64 exec, -1
    s_waitcnt lgkmcnt(0)
    s_barrier
    s_cmp_ge_u32 s76, 5
    s_cbranch_scc1 L_pub2_done
    v_cmp_le_u32 vcc, 160, v0
    v_mov_b32 v9, 0
    v_mov_b32 v11, 12800
    v_cndmask_b32 v10, v9, v11, vcc
    v_lshl_add_u32 v10, v0, 4, v10
    ds_read_b128 v[72:75], v10 offset:8192
    ds_read_b128 v[76:79], v10 offset:10752
    ds_read_b128 v[80:83], v10 offset:13312
    ds_read_b128 v[84:87], v10 offset:15872
    ds_read_b128 v[88:91], v10 offset:18432
    ds_read_b128 v[92:95], v10 offset:20992
    v_mov_b32 v11, 652800
    v_cndmask_b32 v8, v9, v11, vcc
    v_lshl_add_u32 v8, v0, 4, v8
    s_mul_i32 s79, s2, 2560
    s_add_u32 s79, s79, 327680
    s_waitcnt lgkmcnt(0)
    v_add_f32 v72, v72, v76
    v_add_f32 v73, v73, v77
    v_add_f32 v74, v74, v78
    v_add_f32 v75, v75, v79
    v_add_f32 v72, v72, v80
    v_add_f32 v73, v73, v81
    v_add_f32 v74, v74, v82
    v_add_f32 v75, v75, v83
    v_add_f32 v72, v72, v84
    v_add_f32 v73, v73, v85
    v_add_f32 v74, v74, v86
    v_add_f32 v75, v75, v87
    v_add_f32 v72, v72, v88
    v_add_f32 v73, v73, v89
    v_add_f32 v74, v74, v90
    v_add_f32 v75, v75, v91
    v_add_f32 v72, v72, v92
    v_add_f32 v73, v73, v93
    v_add_f32 v74, v74, v94
    v_add_f32 v75, v75, v95
    v_min_u32 v72, -2, v72
    v_min_u32 v73, -2, v73
    v_min_u32 v74, -2, v74
    v_min_u32 v75, -2, v75
    buffer_store_dwordx4 v[72:75], v8, s[40:43], s79 offen sc1
L_pub2_done:
    s_cmp_ge_u32 s2, 40
    s_cbranch_scc1 L_exit
    v_lshrrev_b32 v8, 3, v0
    v_mul_u32_u24 v8, 2560, v8
    v_bfe_u32 v9, v0, 2, 1
    v_mul_u32_u24 v9, 655360, v9
    v_and_b32 v10, 3, v0
    v_lshlrev_b32 v10, 4, v10
    v_add3_u32 v8, v8, v9, v10
    s_lshl_b32 s79, s2, 6
    s_lshl_b32 s81, s2, 5
    s_add_u32 s79, s79, 327680
    v_lshlrev_b32 v11, 1, v0
    buffer_load_ushort v100, v11, s[44:47], s81 offen
    buffer_load_ushort v101, v11, s[60:63], s81 offen
L_poll2:
    s_mov_b32 s80, s79
    buffer_load_dwordx4 v[64:67], v8, s[40:43], s80 offen sc1
    s_add_u32 s80, s80, 163840
    buffer_load_dwordx4 v[68:71], v8, s[40:43], s80 offen sc1
    s_add_u32 s80, s80, 163840
    buffer_load_dwordx4 v[72:75], v8, s[40:43], s80 offen sc1
    s_add_u32 s80, s80, 163840
    buffer_load_dwordx4 v[76:79], v8, s[40:43], s80 offen sc1
    s_waitcnt vmcnt(0)
    v_max3_u32 v6, v64, v65, v66
    v_max3_u32 v6, v6, v67, v68
    v_max3_u32 v6, v6, v69, v70
    v_max3_u32 v6, v6, v71, v72
    v_max3_u32 v6, v6, v73, v74
    v_max3_u32 v6, v6, v75, v76
    v_max3_u32 v6, v6, v77, v78
    v_max_u32 v6, v6, v79
    v_cmp_eq_u32 vcc, -1, v6
    s_nop 4
    s_cbranch_vccz L_poll2_done
    s_sleep 1
    s_branch L_poll2
L_poll2_done:
    v_add_f32 v64, v64, v68
    v_add_f32 v65, v65, v69
    v_add_f32 v66, v66, v70
    v_add_f32 v67, v67, v71
    v_add_f32 v64, v64, v72
    v_add_f32 v65, v65, v73
    v_add_f32 v66, v66, v74
    v_add_f32 v67, v67, v75
    v_add_f32 v64, v64, v76
    v_add_f32 v65, v65, v77
    v_add_f32 v66, v66, v78
    v_add_f32 v67, v67, v79
    s_nop 1
    v_permlane32_swap_b32 v64, v66
    v_permlane32_swap_b32 v65, v67
    v_add_f32 v64, v64, v66
    v_add_f32 v65, v65, v67
    s_nop 1
    v_permlane16_swap_b32 v64, v65
    v_add_f32 v64, v64, v65
    s_nop 1
    v_add_f32_dpp v64, v64, v64 row_ror:8 row_mask:0xf bank_mask:0xf
    v_and_b32 v9, 7, v0
    v_lshlrev_b32 v9, 4, v9
    v_lshrrev_b32 v10, 4, v2
    v_lshl_add_u32 v9, v10, 2, v9
    s_lshl_b32 s80, s76, 7
    v_add_u32 v9, s80, v9
    ds_write_b32 v9, v64
    s_waitcnt lgkmcnt(0)
    s_barrier
    v_cmp_gt_u32 vcc, 16, v0
    s_and_saveexec_b64 s[94:95], vcc
    s_cbranch_execz L_exit
    v_lshlrev_b32 v9, 2, v0
    ds_read_b32 v64, v9 offset:0
    ds_read_b32 v72, v9 offset:64
    ds_read_b32 v65, v9 offset:128
    ds_read_b32 v73, v9 offset:192
    ds_read_b32 v66, v9 offset:256
    ds_read_b32 v74, v9 offset:320
    ds_read_b32 v67, v9 offset:384
    ds_read_b32 v75, v9 offset:448
    ds_read_b32 v68, v9 offset:512
    ds_read_b32 v76, v9 offset:576
    ds_read_b32 v69, v9 offset:640
    ds_read_b32 v77, v9 offset:704
    ds_read_b32 v70, v9 offset:768
    ds_read_b32 v78, v9 offset:832
    ds_read_b32 v71, v9 offset:896
    ds_read_b32 v79, v9 offset:960
    s_waitcnt lgkmcnt(0)
    v_add_f32 v64, v64, v68
    v_add_f32 v72, v72, v76
    v_add_f32 v65, v65, v69
    v_add_f32 v73, v73, v77
    v_add_f32 v66, v66, v70
    v_add_f32 v74, v74, v78
    v_add_f32 v67, v67, v71
    v_add_f32 v75, v75, v79
    v_add_f32 v64, v64, v66
    v_add_f32 v72, v72, v74
    v_add_f32 v65, v65, v67
    v_add_f32 v73, v73, v75
    v_add_f32 v64, v64, v65
    v_add_f32 v72, v72, v73
    v_cvt_pk_bf16_f32 v6, v64, v72
    v_lshlrev_b32 v64, 16, v6
    v_and_b32 v72, 0xffff0000, v6
    v_lshlrev_b32 v101, 16, v101
    v_lshlrev_b32 v100, 16, v100
    v_add_f32 v72, v72, v101
    v_cvt_pk_bf16_f32 v6, v72, v72
    v_lshlrev_b32 v72, 16, v6
    v_mul_f32 v73, 0xbfb8aa3b, v72
    v_exp_f32 v73, v73
    s_nop 0
    v_add_f32 v73, 1.0, v73
    v_rcp_f32 v73, v73
    s_nop 0
    v_mul_f32 v72, v72, v73
    v_cvt_pk_bf16_f32 v6, v72, v72
    v_lshlrev_b32 v72, 16, v6
    v_mul_f32 v64, v64, v72
    v_cvt_pk_bf16_f32 v6, v64, v64
    v_lshlrev_b32 v64, 16, v6
    v_add_f32 v64, v64, v100
    v_cvt_pk_bf16_f32 v64, v64, v64
    buffer_store_short v64, v11, s[64:67], s81 offen
L_exit:
    s_endpgm

.section .rodata,"a"
.p2align 6
.amdhsa_kernel recurrent_scan__mha_block_cached__dense_activation_gelu__decode_kernel
  .amdhsa_next_free_vgpr 256
  .amdhsa_next_free_sgpr 102
  .amdhsa_accum_offset 256
  .amdhsa_group_segment_fixed_size 0
  .amdhsa_kernarg_size 104
  .amdhsa_user_sgpr_count 2
  .amdhsa_user_sgpr_kernarg_segment_ptr 1
  .amdhsa_system_sgpr_workgroup_id_x 1
  .amdhsa_float_denorm_mode_32 3
.end_amdhsa_kernel
```
